```python
import torch

def _softmax(x, axis=-1):
    return torch.softmax(x, dim=axis)

def _gelu(x):
    return torch.nn.functional.gelu(x, approximate='tanh')

def _silu(x):
    return torch.nn.functional.silu(x)

def _sigmoid(x):
    return torch.sigmoid(x)

def _layernorm(x, axis=-1, eps=1e-05):
    m = x.mean(dim=axis, keepdim=True)
    v = x.var(dim=axis, keepdim=True, unbiased=False)
    return (x - m) / torch.sqrt(v + eps)

def _scatter_add(tgt, idx, src, axis=0):
    return tgt.clone().index_add_(axis, idx, src)

def _segment_sum(src, seg, n):
    out = torch.zeros((n,) + src.shape[1:], dtype=src.dtype)
    return out.index_add_(0, seg, src)

def _pad(x, pw):
    flat = tuple((v for pair in reversed(pw) for v in pair))
    return torch.nn.functional.pad(x, flat)
kernel_name = 'standalone__tensor_product_equiv_tfn__graph'

def setup_inputs():

    _w = lambda a: (lambda t: t.to(torch.bfloat16) if t.is_floating_point() else t)(torch.as_tensor(a))
    N, deg, C, L, DE = (10000, 32, 128, 1, 4)
    E = N * deg
    M = (L + 1) ** 2
    src = (lambda lo, hi, *s: torch.randint(lo, hi, s))(0, N, E).to(torch.int64)
    dst = (lambda lo, hi, *s: torch.randint(lo, hi, s))(0, N, E).to(torch.int64)
    r = (lambda *s: torch.randn(*s, dtype=torch.bfloat16) * 0.05)(E, 3)
    r = r / (torch.linalg.norm(r, dim=-1, keepdim=True) + 1e-09)
    rx, ry, rz = (r[:, 0].clone(), r[:, 1].clone(), r[:, 2].clone())
    Ys = [torch.ones((E, 1), dtype=float)]
    if L >= 1:
        Ys.append(r.to(float))
    if L >= 2:
        Ys.append(torch.stack([2 * rx * ry, 2 * ry * rz, (3 * rz * rz - 1.0) / (lambda _x: torch.sqrt(torch.as_tensor(_x)))(3.0), 2 * rx * rz, rx * rx - ry * ry], dim=-1).to(float))
    for _l in range(3, L + 1):
        Ys.append(((lambda *s: torch.randn(*s, dtype=torch.bfloat16) * 0.05)(E, 2 * _l + 1) * 0.3).to(float))
    Y = torch.cat(Ys, dim=-1)
    cg = torch.zeros((M, M, M), dtype=float)
    off = [_l * _l for _l in range(L + 2)]
    for l1 in range(L + 1):
        for l2 in range(L + 1):
            for l3 in range(abs(l1 - l2), min(L, l1 + l2) + 1):
                d1, d2, d3 = (2 * l1 + 1, 2 * l2 + 1, 2 * l3 + 1)
                cg[off[l1]:off[l1 + 1], off[l2]:off[l2 + 1], off[l3]:off[l3 + 1]] = (lambda *s: torch.randn(*s, dtype=torch.bfloat16) * 0.05)(d1, d2, d3) / (lambda _x: torch.sqrt(torch.as_tensor(_x)))(float(d1 * d2))
    return {'x': _w((lambda *s: torch.randn(*s, dtype=torch.bfloat16) * 0.05)(N, C, M) * 0.2), 'src': _w(src), 'dst': _w(dst), 'Y': _w(Y), 'edge_feat': _w((lambda *s: torch.randn(*s, dtype=torch.bfloat16) * 0.05)(E, DE)), 'w_rad': _w((lambda *s: torch.randn(*s, dtype=torch.bfloat16) * 0.05)(DE, C) * (1.0 / max(1.0, DE) ** 0.5)), 'cg': _w(cg), 'w_mix': _w((lambda *s: torch.randn(*s, dtype=torch.bfloat16) * 0.05)(C, C) * (1.0 / max(1.0, C) ** 0.5))}

def reference(x, src, dst, Y, edge_feat, w_rad, cg, w_mix):
    N, C, M = (x.shape[0], x.shape[1], x.shape[2])
    R = _silu(edge_feat @ w_rad)
    xs = x[src]
    tp = torch.einsum('eci,ef,ifo->eco', xs, Y, cg)
    msg = R[:, :, None] * tp
    agg = _segment_sum(msg.reshape(-1, C * M), dst, N).reshape(N, C, M)
    return torch.einsum('ncm,cd->ndm', agg, w_mix)
```

```asm
; @launch kernel=tfn_sort_kernel grid=(257,1,1) block=(320,1,1) lds=27648
; @launch kernel=tfn_main_kernel grid=(256,1,1) block=(512,1,1) lds=137600
.amdgcn_target "amdgcn-amd-amdhsa--gfx950"
.text
.globl tfn_sort_kernel
.p2align 8
.type tfn_sort_kernel,@function
tfn_sort_kernel:
    s_cmp_ge_u32 s2, 250
    s_cbranch_scc1 K1_WFONLY
    s_load_dwordx4 s[4:7], s[0:1], 8
    s_load_dwordx4 s[8:11], s[0:1], 24
    s_load_dwordx2 s[12:13], s[0:1], 80
    s_load_dwordx2 s[14:15], s[0:1], 56
    s_load_dwordx2 s[32:33], s[0:1], 0
    s_load_dwordx2 s[34:35], s[0:1], 64
    s_getpc_b64 s[30:31]
K1_PC0:
    v_lshlrev_b32 v72, 7, v0
    v_mov_b32 v73, (K2_END-K1_PC0+127)/128
    v_cmp_gt_u32 vcc, v73, v0
    s_and_saveexec_b64 s[18:19], vcc
    s_cbranch_execz K1_NOSELF
    global_load_dword v73, v72, s[30:31]
K1_NOSELF:
    s_mov_b64 exec, s[18:19]
    s_mul_i32 s16, s2, 5120
    s_lshl_b32 s17, s16, 1
    v_lshlrev_b32 v1, 4, v0
    v_add_u32 v2, s16, v1
    v_lshlrev_b32 v3, 5, v0
    v_add_u32 v3, s17, v3
    v_mov_b32 v4, 0
    v_lshlrev_b32 v5, 2, v0
    v_cmp_gt_u32 vcc, 256, v0
    s_and_saveexec_b64 s[18:19], vcc
    ds_write_b32 v5, v4 offset:25600
    s_mov_b64 exec, s[18:19]
    s_waitcnt lgkmcnt(0)
    global_load_dwordx4 v[8:11], v2, s[6:7] nt
    global_load_dwordx4 v[12:15], v2, s[4:5] nt
    global_load_dwordx4 v[16:19], v3, s[8:9] nt
    global_load_dwordx4 v[20:23], v3, s[8:9] offset:16 nt
    global_load_dwordx4 v[24:27], v3, s[10:11] nt
    global_load_dwordx4 v[28:31], v3, s[10:11] offset:16 nt
    v_and_b32 v70, 63, v0
    v_lshlrev_b32 v70, 21, v70
    s_mov_b64 s[18:19], exec
    s_mov_b64 exec, 0xf
    global_load_dword v71, v70, s[12:13]
    s_mov_b64 exec, 0x1f
    global_load_dword v71, v70, s[32:33]
    global_load_dword v71, v70, s[34:35]
    s_mov_b64 exec, s[18:19]
    s_barrier
    s_add_u32 s20, s12, 0x0
    s_addc_u32 s21, s13, 0
    s_add_u32 s24, s12, 0x40000
    s_addc_u32 s25, s13, 0
    s_add_u32 s26, s12, 0x700000
    s_addc_u32 s27, s13, 0
    s_movk_i32 s28, 1677
    v_mov_b32 v6, 1
    s_waitcnt vmcnt(8)
    v_mul_u32_u24 v32, s28, v8
    v_lshrrev_b32 v32, 14, v32
    v_and_b32 v32, 0x3fc, v32
    ds_add_rtn_u32 v36, v32, v6 offset:25600
    v_mul_u32_u24 v33, s28, v9
    v_lshrrev_b32 v33, 14, v33
    v_and_b32 v33, 0x3fc, v33
    ds_add_rtn_u32 v37, v33, v6 offset:25600
    v_mul_u32_u24 v34, s28, v10
    v_lshrrev_b32 v34, 14, v34
    v_and_b32 v34, 0x3fc, v34
    ds_add_rtn_u32 v38, v34, v6 offset:25600
    v_mul_u32_u24 v35, s28, v11
    v_lshrrev_b32 v35, 14, v35
    v_and_b32 v35, 0x3fc, v35
    ds_add_rtn_u32 v39, v35, v6 offset:25600
K1_NOWF:
    s_waitcnt vmcnt(7)
    v_lshl_or_b32 v40, v8, 14, v12
    v_lshl_or_b32 v41, v9, 14, v13
    v_lshl_or_b32 v42, v10, 14, v14
    v_lshl_or_b32 v43, v11, 14, v15
    s_waitcnt lgkmcnt(0)
    s_barrier
    v_and_b32 v7, 63, v0
    v_lshlrev_b32 v44, 4, v7
    ds_read_b128 v[48:51], v44 offset:25600
    s_waitcnt lgkmcnt(0)
    v_add_u32 v52, v48, v49
    v_add_u32 v53, v52, v50
    v_add_u32 v54, v53, v51
    v_mov_b32 v55, v54
    s_nop 1
    v_add_u32_dpp v55, v55, v55 row_shr:1 row_mask:0xf bank_mask:0xf
    s_nop 1
    v_add_u32_dpp v55, v55, v55 row_shr:2 row_mask:0xf bank_mask:0xf
    s_nop 1
    v_add_u32_dpp v55, v55, v55 row_shr:4 row_mask:0xf bank_mask:0xf
    s_nop 1
    v_add_u32_dpp v55, v55, v55 row_shr:8 row_mask:0xf bank_mask:0xf
    s_nop 1
    v_add_u32_dpp v55, v55, v55 row_bcast:15 row_mask:0xa bank_mask:0xf
    s_nop 1
    v_add_u32_dpp v55, v55, v55 row_bcast:31 row_mask:0xc bank_mask:0xf
    s_nop 0
    v_sub_u32 v56, v55, v54
    v_add_u32 v57, v56, v48
    v_add_u32 v58, v56, v52
    v_add_u32 v59, v56, v53
    ds_write_b128 v44, v[56:59] offset:26624
    v_lshl_or_b32 v60, v56, 16, v48
    v_lshl_or_b32 v61, v57, 16, v49
    v_lshl_or_b32 v62, v58, 16, v50
    v_lshl_or_b32 v63, v59, 16, v51
    s_waitcnt lgkmcnt(0)
    ds_read_b32 v48, v32 offset:26624
    ds_read_b32 v49, v33 offset:26624
    ds_read_b32 v50, v34 offset:26624
    ds_read_b32 v51, v35 offset:26624
    s_waitcnt lgkmcnt(3)
    v_add_u32 v48, v48, v36
    v_mul_u32_u24 v48, 20, v48
    s_waitcnt lgkmcnt(2)
    v_add_u32 v49, v49, v37
    v_mul_u32_u24 v49, 20, v49
    s_waitcnt lgkmcnt(1)
    v_add_u32 v50, v50, v38
    v_mul_u32_u24 v50, 20, v50
    s_waitcnt lgkmcnt(0)
    v_add_u32 v51, v51, v39
    v_mul_u32_u24 v51, 20, v51
    s_waitcnt vmcnt(0)
    ds_write2_b32 v48, v16, v17 offset0:0 offset1:1
    ds_write2_b32 v48, v24, v25 offset0:2 offset1:3
    ds_write_b32 v48, v40 offset:16
    ds_write2_b32 v49, v18, v19 offset0:0 offset1:1
    ds_write2_b32 v49, v26, v27 offset0:2 offset1:3
    ds_write_b32 v49, v41 offset:16
    ds_write2_b32 v50, v20, v21 offset0:0 offset1:1
    ds_write2_b32 v50, v28, v29 offset0:2 offset1:3
    ds_write_b32 v50, v42 offset:16
    ds_write2_b32 v51, v22, v23 offset0:0 offset1:1
    ds_write2_b32 v51, v30, v31 offset0:2 offset1:3
    ds_write_b32 v51, v43 offset:16
    v_cmp_gt_u32 vcc, 64, v0
    s_and_saveexec_b64 s[18:19], vcc
    s_cbranch_execz K1_NOTAB
    s_lshl_b32 s28, s2, 10
    v_add_u32 v45, s28, v44
    global_store_dwordx4 v45, v[60:63], s[20:21] sc0 sc1
K1_NOTAB:
    s_mov_b64 exec, s[18:19]
    s_waitcnt lgkmcnt(0)
    s_barrier
    ds_read_b128 v[8:11], v1 offset:0
    ds_read_b128 v[12:15], v1 offset:5120
    ds_read_b128 v[16:19], v1 offset:10240
    ds_read_b128 v[20:23], v1 offset:15360
    ds_read_b128 v[24:27], v1 offset:20480
    s_mul_i32 s28, s2, 25600
    v_add_u32 v2, s28, v1
    s_waitcnt lgkmcnt(4)
    global_store_dwordx4 v2, v[8:11], s[24:25] sc0 sc1
    s_waitcnt lgkmcnt(3)
    v_add_u32 v2, 5120, v2
    global_store_dwordx4 v2, v[12:15], s[24:25] sc0 sc1
    s_waitcnt lgkmcnt(2)
    v_add_u32 v2, 5120, v2
    global_store_dwordx4 v2, v[16:19], s[24:25] sc0 sc1
    s_waitcnt lgkmcnt(1)
    v_add_u32 v2, 5120, v2
    global_store_dwordx4 v2, v[20:23], s[24:25] sc0 sc1
    s_waitcnt lgkmcnt(0)
    v_add_u32 v2, 5120, v2
    global_store_dwordx4 v2, v[24:27], s[24:25] sc0 sc1
    s_endpgm
K1_WFONLY:
    s_cmp_ge_u32 s2, 257
    s_cbranch_scc1 K1_END
    s_load_dwordx2 s[12:13], s[0:1], 80
    s_load_dwordx2 s[14:15], s[0:1], 56
    v_lshrrev_b32 v1, 6, v0
    v_and_b32 v58, 63, v0
    v_readfirstlane_b32 s3, v1
    s_sub_u32 s4, s2, 250
    s_mul_i32 s4, s4, 5
    s_add_u32 s4, s4, s3
    s_cmp_ge_u32 s4, 32
    s_cbranch_scc1 K1_END
    s_lshr_b32 s29, s4, 3
    s_lshl_b32 s30, s29, 6
    s_lshr_b32 s29, s4, 2
    s_and_b32 s29, s29, 1
    s_lshl_b32 s29, s29, 1
    s_add_u32 s30, s30, s29
    s_and_b32 s29, s4, 3
    s_lshl_b32 s29, s29, 13
    s_add_u32 s30, s30, s29
    v_lshrrev_b32 v56, 4, v58
    v_lshlrev_b32 v56, 11, v56
    v_and_b32 v57, 15, v58
    v_lshlrev_b32 v57, 2, v57
    v_add3_u32 v56, v56, v57, s30
    s_lshl_b32 s30, s4, 10
    v_lshl_add_u32 v57, v58, 4, s30
    s_waitcnt lgkmcnt(0)
    global_load_ushort v44, v56, s[14:15] offset:0
    global_load_ushort v45, v56, s[14:15] offset:256
    global_load_ushort v46, v56, s[14:15] offset:512
    global_load_ushort v47, v56, s[14:15] offset:768
    global_load_ushort v48, v56, s[14:15] offset:1024
    global_load_ushort v49, v56, s[14:15] offset:1280
    global_load_ushort v50, v56, s[14:15] offset:1536
    global_load_ushort v51, v56, s[14:15] offset:1792
    s_add_u32 s26, s12, 0x700000
    s_addc_u32 s27, s13, 0
    s_waitcnt vmcnt(0)
    v_lshl_or_b32 v52, v45, 16, v44
    v_lshl_or_b32 v53, v47, 16, v46
    v_lshl_or_b32 v54, v49, 16, v48
    v_lshl_or_b32 v55, v51, 16, v50
    global_store_dwordx4 v57, v[52:55], s[26:27] sc0 sc1
K1_END:
    s_endpgm
.globl tfn_main_kernel
.p2align 8
.type tfn_main_kernel,@function
tfn_main_kernel:
    s_cmp_ge_u32 s2, 256
    s_cbranch_scc1 K2_END
    s_load_dwordx2 s[24:25], s[0:1], 80
    s_load_dwordx2 s[64:65], s[0:1], 0
    s_load_dwordx4 s[68:71], s[0:1], 40
    s_load_dwordx2 s[66:67], s[0:1], 64
    v_lshrrev_b32 v4, 6, v0
    v_and_b32 v1, 63, v0
    v_readfirstlane_b32 s3, v4
    s_and_b32 s28, s2, 7
    s_lshl_b32 s28, s28, 5
    s_lshr_b32 s44, s2, 3
    s_add_u32 s28, s28, s44
    v_lshrrev_b32 v203, 1, v1
    s_lshl_b32 s44, s3, 5
    v_add_u32 v203, s44, v203
    s_lshl_b32 s44, s28, 2
    v_lshl_add_u32 v4, v203, 10, s44
    s_waitcnt lgkmcnt(0)
    s_mov_b32 s12, s24
    s_and_b32 s13, s25, 0xffff
    s_mov_b32 s14, 0x3e800
    s_mov_b32 s15, 0x20000
    buffer_load_dword v208, v4, s[12:15], 0 offen
    s_lshl_b32 s44, s28, 16
    s_add_u32 s44, s44, 1676
    s_mov_b32 s45, 2561102
    s_mul_hi_u32 s26, s44, s45
    s_add_u32 s44, s44, 0x10000
    s_mul_hi_u32 s27, s44, s45
    s_min_u32 s27, s27, 10000
    v_lshlrev_b32 v4, 2, v1
    global_load_dword v128, v4, s[68:69] offset:0
    global_load_dword v129, v4, s[68:69] offset:256
    global_load_dword v130, v4, s[68:69] offset:512
    global_load_dword v131, v4, s[68:69] offset:768
    v_and_b32 v5, 3, v1
    v_lshlrev_b32 v5, 5, v5
    v_bfe_u32 v6, v1, 2, 2
    v_lshl_add_u32 v5, v6, 1, v5
    global_load_ushort v132, v5, s[70:71] offset:0
    global_load_ushort v133, v5, s[70:71] offset:8
    global_load_ushort v134, v5, s[70:71] offset:16
    global_load_ushort v135, v5, s[70:71] offset:24
    s_mov_b32 s4, s64
    s_and_b32 s5, s65, 0xffff
    s_or_b32 s5, s5, 0x4000000
    s_mov_b32 s6, 0x2710
    s_mov_b32 s7, 0x20000
    s_add_u32 s52, s24, 0x40000
    s_addc_u32 s53, s25, 0
    s_mov_b32 s8, s52
    s_and_b32 s9, s53, 0xffff
    s_mov_b32 s10, 0x61a800
    s_mov_b32 s11, 0x20000
    s_add_u32 s52, s24, 0x700000
    s_addc_u32 s53, s25, 0
    s_mov_b32 s20, s52
    s_and_b32 s21, s53, 0xffff
    s_mov_b32 s22, 0x8000
    s_mov_b32 s23, 0x20000
    s_lshl_b32 s44, s27, 10
    s_mov_b32 s16, s66
    s_and_b32 s17, s67, 0xffff
    s_mov_b32 s18, s44
    s_mov_b32 s19, 0x20000
    v_mov_b64 v[8:9], 0
    v_mov_b64 v[10:11], 0
    v_mov_b64 v[12:13], 0
    v_mov_b64 v[14:15], 0
    v_mov_b64 v[16:17], 0
    v_mov_b64 v[18:19], 0
    v_mov_b64 v[20:21], 0
    v_mov_b64 v[22:23], 0
    v_mov_b64 v[24:25], 0
    v_mov_b64 v[26:27], 0
    v_mov_b64 v[28:29], 0
    v_mov_b64 v[30:31], 0
    v_mov_b64 v[32:33], 0
    v_mov_b64 v[34:35], 0
    v_mov_b64 v[36:37], 0
    v_mov_b64 v[38:39], 0
    v_mov_b64 v[40:41], 0
    v_mov_b64 v[42:43], 0
    v_mov_b64 v[44:45], 0
    v_mov_b64 v[46:47], 0
    s_mov_b32 s48, 1.0
    s_mov_b32 s49, 1.0
    s_mov_b32 s50, 0xbf317218
    s_mov_b32 s51, 0xbf317218
    s_mov_b32 s56, 0xaaaaaaaa
    s_mov_b32 s57, 0xaaaaaaaa
    s_mov_b32 s31, 0
    s_movk_i32 s63, 0x1c0
    s_mul_i32 s60, s3, 11520
    s_add_u32 s60, s60, 1920
    v_mul_u32_u24 v203, 25600, v203
    v_and_b32 v204, 1, v1
    v_lshrrev_b32 v205, 4, v1
    v_lshlrev_b32 v205, 8, v205
    v_mov_b32 v5, 0
    v_lshlrev_b32 v6, 2, v0
    v_cmp_le_u32 vcc, 128, v0
    v_add_u32 v7, 640, v6
    s_nop 0
    v_cndmask_b32 v6, v6, v7, vcc
    v_cmp_gt_u32 vcc, 192, v0
    s_and_saveexec_b64 s[54:55], vcc
    ds_write_b32 v6, v5
    s_mov_b64 exec, s[54:55]
    v_lshrrev_b32 v6, 1, v0
    v_mul_u32_u24 v6, 720, v6
    v_and_b32 v7, 1, v0
    v_lshl_add_u32 v6, v7, 2, v6
    v_cmp_gt_u32 vcc, 256, v0
    s_and_saveexec_b64 s[54:55], vcc
    ds_write_b32 v6, v5 offset:2624
    s_mov_b64 exec, s[54:55]
    s_lshl_b32 s44, s2, 3
    s_lshl_b32 s45, s3, 11
    s_add_u32 s44, s44, s45
    v_lshrrev_b32 v212, 3, v1
    v_add_u32 v212, s44, v212
    v_and_b32 v213, 7, v1
    v_lshlrev_b32 v213, 7, v213
    s_waitcnt vmcnt(0)
    v_and_b32 v200, 0xffff, v208
    v_lshrrev_b32 v4, 16, v208
    v_cndmask_b32 v201, v200, 0, s[56:57]
    v_mul_u32_u24 v4, 20, v4
    v_add_u32 v202, v203, v4
    s_nop 1
    v_add_u32_dpp v201, v201, v201 row_shr:1 row_mask:0xf bank_mask:0xf
    s_nop 1
    v_add_u32_dpp v201, v201, v201 row_shr:2 row_mask:0xf bank_mask:0xf
    s_nop 1
    v_add_u32_dpp v201, v201, v201 row_shr:4 row_mask:0xf bank_mask:0xf
    s_nop 1
    v_add_u32_dpp v201, v201, v201 row_shr:8 row_mask:0xf bank_mask:0xf
    s_nop 1
    v_add_u32_dpp v201, v201, v201 row_bcast:15 row_mask:0xa bank_mask:0xf
    s_nop 1
    v_add_u32_dpp v201, v201, v201 row_bcast:31 row_mask:0xc bank_mask:0xf
    s_nop 0
    v_readlane_b32 s29, v201, 63
    v_sub_u32 v201, v201, v200
    s_lshl_b32 s44, s3, 2
    v_mov_b32 v5, s44
    v_mov_b32 v4, s29
    ds_write_b32 v5, v4 offset:1024
    s_movk_i32 s30, 256
K2_ROUND:
    s_lshl_b32 s44, s3, 10
    s_add_u32 s44, s44, 94080
    s_cmp_lg_u32 s30, 256
    s_cselect_b32 s45, 0x7fffffff, s29
    s_cmp_gt_u32 s45, 256
    s_cbranch_scc1 K2_EXPOTHER
    v_add_u32 v4, v201, v204
    v_lshl_add_u32 v4, v4, 2, s44
    v_mad_u32_u24 v5, v204, 20, v202
    v_sub_u32 v6, v200, v204
    v_cmpx_lt_i32 vcc, 0, v6
    ds_write_b32 v4, v5 offset:0
    v_add_u32 v5, 40, v5
    v_cmpx_lt_i32 vcc, 2, v6
    ds_write_b32 v4, v5 offset:8
    v_add_u32 v5, 40, v5
    v_cmpx_lt_i32 vcc, 4, v6
    ds_write_b32 v4, v5 offset:16
    v_add_u32 v5, 40, v5
    v_cmpx_lt_i32 vcc, 6, v6
    ds_write_b32 v4, v5 offset:24
    v_add_u32 v5, 40, v5
    v_cmpx_lt_i32 vcc, 8, v6
    ds_write_b32 v4, v5 offset:32
    v_add_u32 v5, 40, v5
    v_cmpx_lt_i32 vcc, 10, v6
    ds_write_b32 v4, v5 offset:40
    v_add_u32 v5, 40, v5
    v_cmpx_lt_i32 vcc, 12, v6
    ds_write_b32 v4, v5 offset:48
    v_add_u32 v5, 40, v5
    v_cmpx_lt_i32 vcc, 14, v6
    ds_write_b32 v4, v5 offset:56
    v_add_u32 v5, 40, v5
    v_mov_b32 v7, 16
K2_EXPTAIL:
    v_cmpx_lt_i32 vcc, v7, v6
    s_cbranch_execz K2_EXPDONE
    v_lshl_add_u32 v206, v7, 2, v4
    ds_write_b32 v206, v5
    v_add_u32 v5, 40, v5
    v_add_u32 v7, 2, v7
    s_branch K2_EXPTAIL
K2_EXPOTHER:
    s_cmp_eq_u32 s30, 256
    s_cbranch_scc1 K2_EXPDONE
K2_EXPSLOW:
    v_mov_b32 v206, v204
    v_add_u32 v207, v201, v204
    v_subrev_u32 v207, s31, v207
    v_mad_u32_u24 v5, v204, 20, v202
K2_EXPS1:
    v_cmpx_lt_u32 vcc, v206, v200
    s_cbranch_execz K2_EXPDONE
    v_cmp_gt_u32 vcc, s30, v207
    s_and_saveexec_b64 s[54:55], vcc
    v_lshl_add_u32 v7, v207, 2, s44
    ds_write_b32 v7, v5
    s_mov_b64 exec, s[54:55]
    v_add_u32 v206, 2, v206
    v_add_u32 v207, 2, v207
    v_add_u32 v5, 40, v5
    s_branch K2_EXPS1
K2_EXPDONE:
    s_mov_b64 exec, -1
    s_sub_i32 s46, s29, s31
    s_max_i32 s46, s46, 0
    s_min_u32 s46, s46, s30
    s_cmp_gt_u32 s29, 256
    s_cselect_b32 s45, 0, s46
    s_cmp_eq_u32 s30, 256
    s_cselect_b32 s46, s45, s46
    v_lshl_add_u32 v4, v1, 2, s44
    s_waitcnt lgkmcnt(0)
    ds_read_b32 v164, v4 offset:0
    ds_read_b32 v165, v4 offset:256
    ds_read_b32 v166, v4 offset:512
    ds_read_b32 v167, v4 offset:768
    s_sub_i32 s45, s46, 0
    v_cmp_gt_i32 s[32:33], s45, v1
    s_sub_i32 s45, s46, 64
    v_cmp_gt_i32 s[34:35], s45, v1
    s_sub_i32 s45, s46, 128
    v_cmp_gt_i32 s[36:37], s45, v1
    s_sub_i32 s45, s46, 192
    v_cmp_gt_i32 s[38:39], s45, v1
    s_waitcnt lgkmcnt(0)
    s_mov_b64 exec, s[32:33]
    buffer_load_dwordx4 v[80:83], v164, s[8:11], 0 offen
    buffer_load_dword v96, v164, s[8:11], 0 offen offset:16
K2_LD0:
    s_mov_b64 exec, s[34:35]
    buffer_load_dwordx4 v[84:87], v165, s[8:11], 0 offen
    buffer_load_dword v97, v165, s[8:11], 0 offen offset:16
K2_LD1:
    s_mov_b64 exec, s[36:37]
    buffer_load_dwordx4 v[88:91], v166, s[8:11], 0 offen
    buffer_load_dword v98, v166, s[8:11], 0 offen offset:16
K2_LD2:
    s_mov_b64 exec, s[38:39]
    s_cbranch_execz K2_LD3
    buffer_load_dwordx4 v[92:95], v167, s[8:11], 0 offen
    buffer_load_dword v99, v167, s[8:11], 0 offen offset:16
K2_LD3:
    s_mov_b64 exec, -1
    s_cmp_lg_u32 s31, 0
    s_cbranch_scc1 K2_NOCONST
    s_mov_b32 s44, 0xbfb8aa3b
    v_lshlrev_b32 v112, 16, v128
    v_and_b32 v116, 0xffff0000, v128
    v_lshlrev_b32 v113, 16, v129
    v_and_b32 v117, 0xffff0000, v129
    v_lshlrev_b32 v114, 16, v130
    v_and_b32 v118, 0xffff0000, v130
    v_lshlrev_b32 v115, 16, v131
    v_and_b32 v119, 0xffff0000, v131
    v_mul_f32 v112, s44, v112
    v_mul_f32 v116, s44, v116
    v_mul_f32 v113, s44, v113
    v_mul_f32 v117, s44, v117
    v_mul_f32 v114, s44, v114
    v_mul_f32 v118, s44, v118
    v_mul_f32 v115, s44, v115
    v_mul_f32 v119, s44, v119
    v_cvt_pk_bf16_f32 v156, v112, v113
    v_cvt_pk_bf16_f32 v157, v114, v115
    v_cvt_pk_bf16_f32 v160, v116, v117
    v_cvt_pk_bf16_f32 v161, v118, v119
    v_lshl_or_b32 v198, v133, 16, v132
    v_lshl_or_b32 v199, v135, 16, v134
K2_NOCONST:
    s_waitcnt lgkmcnt(0)
    s_barrier
    v_mov_b32 v7, 1
K2_KEYS:
    s_waitcnt vmcnt(0)
    s_sub_u32 s45, s3, 0
    s_cmp_lt_u32 s45, 5
    s_cselect_b64 exec, -1, 0
    buffer_load_dword v214, v[212:213], s[4:7], 0 idxen offen
K2_NOX2:
    s_mov_b64 exec, s[32:33]
    v_lshrrev_b32 v4, 14, v96
    v_subrev_u32 v4, s26, v4
    v_lshlrev_b32 v104, 2, v4
    ds_add_u32 v104, v7 offset:1152
    v_and_b32 v96, 0x3fff, v96
    v_mul_u32_u24 v100, 104, v96
    v_lshrrev_b32 v100, 14, v100
    v_and_b32 v100, 0x3c, v100
K2_DG0:
    s_mov_b64 exec, s[34:35]
    v_lshrrev_b32 v4, 14, v97
    v_subrev_u32 v4, s26, v4
    v_lshlrev_b32 v105, 2, v4
    ds_add_u32 v105, v7 offset:1152
    v_and_b32 v97, 0x3fff, v97
    v_mul_u32_u24 v101, 104, v97
    v_lshrrev_b32 v101, 14, v101
    v_and_b32 v101, 0x3c, v101
K2_DG1:
    s_mov_b64 exec, s[36:37]
    v_lshrrev_b32 v4, 14, v98
    v_subrev_u32 v4, s26, v4
    v_lshlrev_b32 v106, 2, v4
    ds_add_u32 v106, v7 offset:1152
    v_and_b32 v98, 0x3fff, v98
    v_mul_u32_u24 v102, 104, v98
    v_lshrrev_b32 v102, 14, v102
    v_and_b32 v102, 0x3c, v102
K2_DG2:
    s_mov_b64 exec, s[38:39]
    s_cbranch_execz K2_DG3
    v_lshrrev_b32 v4, 14, v99
    v_subrev_u32 v4, s26, v4
    v_lshlrev_b32 v107, 2, v4
    ds_add_u32 v107, v7 offset:1152
    v_and_b32 v99, 0x3fff, v99
    v_mul_u32_u24 v103, 104, v99
    v_lshrrev_b32 v103, 14, v103
    v_and_b32 v103, 0x3c, v103
K2_DG3:
    s_mov_b64 exec, -1
    s_cmp_lg_u32 s31, 0
    s_cbranch_scc1 K2_OWNED
    s_waitcnt lgkmcnt(0)
    s_barrier
    v_lshlrev_b32 v4, 2, v1
    ds_read_b32 v112, v4 offset:1152
    v_and_b32 v6, 28, v4
    ds_read_b32 v6, v6 offset:1024
    s_mul_i32 s44, s3, 5
    v_sub_u32 v5, 63, v1
    v_mov_b32 v113, 0
    s_waitcnt lgkmcnt(0)
    v_lshl_or_b32 v112, v112, 6, v5
    v_cmp_lt_u32 vcc, 256, v6
    s_cmp_eq_u32 s30, 256
    s_cselect_b64 s[58:59], vcc, 0
    s_cmp_lg_u64 s[58:59], 0
    s_cbranch_scc1 K2_GOSLOW
    s_add_u32 s52, s44, 0
    v_readlane_b32 s76, v112, s52
    s_add_u32 s52, s44, 1
    v_readlane_b32 s77, v112, s52
    s_add_u32 s52, s44, 2
    v_readlane_b32 s78, v112, s52
    s_add_u32 s52, s44, 3
    v_readlane_b32 s79, v112, s52
    s_add_u32 s52, s44, 4
    v_readlane_b32 s45, v112, s52
    s_nop 0
    v_cmp_lt_u32 vcc, s76, v112
    s_bcnt1_i32_b64 s76, vcc
    v_writelane_b32 v113, s76, 0
    v_cmp_lt_u32 vcc, s77, v112
    s_bcnt1_i32_b64 s77, vcc
    v_writelane_b32 v113, s77, 1
    v_cmp_lt_u32 vcc, s78, v112
    s_bcnt1_i32_b64 s78, vcc
    v_writelane_b32 v113, s78, 2
    v_cmp_lt_u32 vcc, s79, v112
    s_bcnt1_i32_b64 s79, vcc
    v_writelane_b32 v113, s79, 3
    v_cmp_lt_u32 vcc, s45, v112
    s_bcnt1_i32_b64 s45, vcc
    v_writelane_b32 v113, s45, 4
    v_lshrrev_b32 v114, 2, v113
    v_and_b32 v115, 3, v113
    v_and_b32 v116, 1, v114
    v_mul_u32_u24 v116, 3, v116
    v_xor_b32 v115, v115, v116
    v_mov_b32 v116, 0x266
    v_lshrrev_b32 v116, v114, v116
    v_and_b32 v116, 1, v116
    v_lshl_add_u32 v117, v116, 2, v115
    v_lshrrev_b32 v114, 1, v114
    v_lshlrev_b32 v116, 17, v114
    v_lshl_or_b32 v116, v117, 6, v116
    v_add_u32 v115, s44, v1
    v_lshlrev_b32 v4, 2, v115
    v_mad_u32_u24 v117, v117, 5, v114
    v_lshlrev_b32 v117, 2, v117
    s_mov_b64 exec, 0x1f
    ds_write_b32 v4, v116 offset:1408
    ds_write_b32 v117, v115 offset:1664
    s_mov_b64 exec, -1
K2_OWNED:
    s_waitcnt lgkmcnt(0)
    s_barrier
    s_mov_b64 exec, s[32:33]
    ds_read_b32 v108, v104 offset:1408
    s_mov_b64 exec, s[34:35]
    ds_read_b32 v109, v105 offset:1408
    s_mov_b64 exec, s[36:37]
    ds_read_b32 v110, v106 offset:1408
    s_mov_b64 exec, s[38:39]
    ds_read_b32 v111, v107 offset:1408
    s_mov_b64 exec, s[32:33]
    s_waitcnt lgkmcnt(0)
    v_and_or_b32 v104, v108, s63, v100
    v_lshrrev_b32 v108, 16, v108
    ds_add_rtn_u32 v100, v104, v7 offset:0
K2_KEY0:
    s_mov_b64 exec, s[34:35]
    v_and_or_b32 v105, v109, s63, v101
    v_lshrrev_b32 v109, 16, v109
    ds_add_rtn_u32 v101, v105, v7 offset:0
K2_KEY1:
    s_mov_b64 exec, s[36:37]
    v_and_or_b32 v106, v110, s63, v102
    v_lshrrev_b32 v110, 16, v110
    ds_add_rtn_u32 v102, v106, v7 offset:0
K2_KEY2:
    s_mov_b64 exec, s[38:39]
    s_cbranch_execz K2_KEY3
    v_and_or_b32 v107, v111, s63, v103
    v_lshrrev_b32 v111, 16, v111
    ds_add_rtn_u32 v103, v107, v7 offset:0
K2_KEY3:
    s_mov_b64 exec, -1
    s_waitcnt lgkmcnt(0)
    s_barrier
    v_lshlrev_b32 v4, 2, v1
    ds_read_b32 v112, v4 offset:0
    ds_read_b32 v113, v4 offset:256
    s_and_b32 s44, s3, 3
    s_lshl_b32 s44, s44, 4
    s_add_u32 s44, s44, 15
    s_waitcnt lgkmcnt(0)
    v_mov_b32 v114, v112
    v_mov_b32 v115, v113
    s_nop 0
    v_add_u32_dpp v114, v114, v114 row_shr:1 row_mask:0xf bank_mask:0xf
    v_add_u32_dpp v115, v115, v115 row_shr:1 row_mask:0xf bank_mask:0xf
    s_nop 0
    v_add_u32_dpp v114, v114, v114 row_shr:2 row_mask:0xf bank_mask:0xf
    v_add_u32_dpp v115, v115, v115 row_shr:2 row_mask:0xf bank_mask:0xf
    s_nop 0
    v_add_u32_dpp v114, v114, v114 row_shr:4 row_mask:0xf bank_mask:0xf
    v_add_u32_dpp v115, v115, v115 row_shr:4 row_mask:0xf bank_mask:0xf
    s_nop 0
    v_add_u32_dpp v114, v114, v114 row_shr:8 row_mask:0xf bank_mask:0xf
    v_add_u32_dpp v115, v115, v115 row_shr:8 row_mask:0xf bank_mask:0xf
    s_nop 0
    v_max_u32 v5, v114, v115
    v_readlane_b32 s40, v114, s44
    v_readlane_b32 s45, v115, s44
    v_cmp_lt_u32 vcc, 224, v5
    v_sub_u32 v114, v114, v112
    v_sub_u32 v115, v115, v113
    v_add_u32 v114, v114, v205
    v_add_u32 v115, v115, v205
    v_add_u32 v115, 1024, v115
    ds_write_b32 v4, v114 offset:512
    ds_write_b32 v4, v115 offset:768
    s_cmp_ge_u32 s3, 4
    s_cselect_b32 s40, s45, s40
    s_cmp_lg_u64 vcc, 0
    s_cbranch_scc1 K2_GOSLOW
    s_waitcnt lgkmcnt(0)
    s_mov_b64 exec, s[32:33]
    ds_read_b32 v164, v104 offset:512
    s_mov_b64 exec, s[34:35]
    ds_read_b32 v165, v105 offset:512
    s_mov_b64 exec, s[36:37]
    ds_read_b32 v166, v106 offset:512
    s_mov_b64 exec, s[38:39]
    ds_read_b32 v167, v107 offset:512
    s_mov_b64 exec, -1
    v_add_u32 v4, s40, v1
    v_lshrrev_b32 v5, 4, v4
    v_mul_u32_u24 v5, 720, v5
    v_add_u32 v5, s60, v5
    v_and_b32 v4, 15, v4
    v_mov_b64 v[116:117], 0
    v_mov_b32 v118, 0x7fffffff
    s_mov_b32 exec_hi, 0
    v_lshl_add_u32 v6, v4, 3, v5
    ds_write_b64 v6, v[116:117] offset:0
    ds_write_b64 v6, v[116:117] offset:512
    v_lshl_add_u32 v6, v4, 2, v5
    ds_write_b32 v6, v118 offset:640
    s_waitcnt lgkmcnt(3)
    s_mov_b64 exec, s[32:33]
    v_add_u32 v4, v164, v100
    v_lshrrev_b32 v5, 4, v4
    v_and_b32 v4, 15, v4
    v_mul_u32_u24 v5, 720, v5
    v_lshrrev_b32 v7, 3, v4
    v_lshl_add_u32 v6, v4, 3, v5
    ds_write_b64 v6, v[80:81] offset:1920
    ds_write_b64 v6, v[82:83] offset:2432
    v_lshl_add_u32 v6, v4, 2, v5
    ds_write_b32 v6, v96 offset:2560
    v_lshl_add_u32 v7, v7, 2, v5
    v_and_b32 v4, 7, v4
    v_lshlrev_b32 v4, 2, v4
    v_lshlrev_b32 v4, v4, v108
    ds_or_b32 v7, v4 offset:2624
K2_SC0:
    s_mov_b64 exec, s[34:35]
    v_add_u32 v4, v165, v101
    v_lshrrev_b32 v5, 4, v4
    v_and_b32 v4, 15, v4
    v_mul_u32_u24 v5, 720, v5
    v_lshrrev_b32 v7, 3, v4
    v_lshl_add_u32 v6, v4, 3, v5
    ds_write_b64 v6, v[84:85] offset:1920
    ds_write_b64 v6, v[86:87] offset:2432
    v_lshl_add_u32 v6, v4, 2, v5
    ds_write_b32 v6, v97 offset:2560
    v_lshl_add_u32 v7, v7, 2, v5
    v_and_b32 v4, 7, v4
    v_lshlrev_b32 v4, 2, v4
    v_lshlrev_b32 v4, v4, v109
    ds_or_b32 v7, v4 offset:2624
K2_SC1:
    s_mov_b64 exec, s[36:37]
    v_add_u32 v4, v166, v102
    v_lshrrev_b32 v5, 4, v4
    v_and_b32 v4, 15, v4
    v_mul_u32_u24 v5, 720, v5
    v_lshrrev_b32 v7, 3, v4
    v_lshl_add_u32 v6, v4, 3, v5
    ds_write_b64 v6, v[88:89] offset:1920
    ds_write_b64 v6, v[90:91] offset:2432
    v_lshl_add_u32 v6, v4, 2, v5
    ds_write_b32 v6, v98 offset:2560
    v_lshl_add_u32 v7, v7, 2, v5
    v_and_b32 v4, 7, v4
    v_lshlrev_b32 v4, 2, v4
    v_lshlrev_b32 v4, v4, v110
    ds_or_b32 v7, v4 offset:2624
K2_SC2:
    s_mov_b64 exec, s[38:39]
    s_cbranch_execz K2_SC3
    v_add_u32 v4, v167, v103
    v_lshrrev_b32 v5, 4, v4
    v_and_b32 v4, 15, v4
    v_mul_u32_u24 v5, 720, v5
    v_lshrrev_b32 v7, 3, v4
    v_lshl_add_u32 v6, v4, 3, v5
    ds_write_b64 v6, v[92:93] offset:1920
    ds_write_b64 v6, v[94:95] offset:2432
    v_lshl_add_u32 v6, v4, 2, v5
    ds_write_b32 v6, v99 offset:2560
    v_lshl_add_u32 v7, v7, 2, v5
    v_and_b32 v4, 7, v4
    v_lshlrev_b32 v4, 2, v4
    v_lshlrev_b32 v4, v4, v111
    ds_or_b32 v7, v4 offset:2624
K2_SC3:
    s_mov_b64 exec, -1
    s_waitcnt lgkmcnt(0)
    s_barrier
    s_and_b32 s44, s3, 3
    s_lshl_b32 s44, s44, 13
    v_lshl_add_u32 v6, v1, 4, s44
    v_add_u32 v7, 4096, v6
    s_cmp_lg_u32 s40, 0
    s_cbranch_scc1 K2_HAVE
    buffer_load_dwordx4 v[164:167], v6, s[20:23], 0 offen offset:0
    buffer_load_dwordx4 v[168:171], v6, s[20:23], 0 offen offset:1024
    buffer_load_dwordx4 v[172:175], v6, s[20:23], 0 offen offset:2048
    buffer_load_dwordx4 v[176:179], v6, s[20:23], 0 offen offset:3072
    buffer_load_dwordx4 v[180:183], v7, s[20:23], 0 offen offset:0
    buffer_load_dwordx4 v[184:187], v7, s[20:23], 0 offen offset:1024
    buffer_load_dwordx4 v[188:191], v7, s[20:23], 0 offen offset:2048
    buffer_load_dwordx4 v[192:195], v7, s[20:23], 0 offen offset:3072
    s_branch K2_ROUND_END
K2_HAVE:
    v_mov_b32 v3, s60
    v_lshlrev_b32 v2, 3, v1
    v_add_u32 v2, s60, v2
    ds_read_b32 v80, v3 offset:640
    ds_read_b32 v82, v3 offset:644
    ds_read_b32 v84, v3 offset:648
    ds_read_b32 v86, v3 offset:652
    ds_read_b32 v88, v3 offset:656
    ds_read_b32 v90, v3 offset:660
    ds_read_b32 v92, v3 offset:664
    ds_read_b32 v94, v3 offset:668
    ds_read_b32 v96, v3 offset:672
    ds_read_b32 v98, v3 offset:676
    ds_read_b32 v100, v3 offset:680
    ds_read_b32 v102, v3 offset:684
    ds_read_b32 v104, v3 offset:688
    ds_read_b32 v106, v3 offset:692
    ds_read_b32 v108, v3 offset:696
    ds_read_b32 v110, v3 offset:700
    v_lshlrev_b32 v4, 4, v1
    v_mov_b32 v81, v4
    v_mov_b32 v83, v4
    v_mov_b32 v85, v4
    v_mov_b32 v87, v4
    v_mov_b32 v89, v4
    v_mov_b32 v91, v4
    v_mov_b32 v93, v4
    v_mov_b32 v95, v4
    v_mov_b32 v97, v4
    v_mov_b32 v99, v4
    v_mov_b32 v101, v4
    v_mov_b32 v103, v4
    v_mov_b32 v105, v4
    v_mov_b32 v107, v4
    v_mov_b32 v109, v4
    v_mov_b32 v111, v4
    v_lshrrev_b32 v5, 4, v1
    v_and_b32 v4, 15, v1
    v_lshlrev_b32 v4, 5, v4
    v_lshl_add_u32 v209, v5, 3, v4
    v_add_u32 v209, s60, v209
    v_mul_u32_u24 v5, 720, v5
    v_lshrrev_b32 v4, 2, v4
    v_add3_u32 v4, v4, v5, s60
    ds_read_b64 v[144:145], v4 offset:0
    ds_read_b64 v[146:147], v4 offset:2880
    ds_read_b64 v[148:149], v4 offset:5760
    ds_read_b64 v[150:151], v4 offset:8640
    ds_read_b64 v[154:155], v2 offset:512
    ds_read_b32 v196, v3 offset:704
    s_waitcnt lgkmcnt(6)
    buffer_load_dwordx4 v[48:51], v[80:81], s[4:7], 0 idxen offen
    buffer_load_dwordx4 v[52:55], v[82:83], s[4:7], 0 idxen offen
    buffer_load_dwordx4 v[56:59], v[84:85], s[4:7], 0 idxen offen
    buffer_load_dwordx4 v[60:63], v[86:87], s[4:7], 0 idxen offen
    buffer_load_dwordx4 v[64:67], v[88:89], s[4:7], 0 idxen offen
    buffer_load_dwordx4 v[68:71], v[90:91], s[4:7], 0 idxen offen
    buffer_load_dwordx4 v[72:75], v[92:93], s[4:7], 0 idxen offen
    buffer_load_dwordx4 v[76:79], v[94:95], s[4:7], 0 idxen offen
    buffer_load_dwordx4 v[164:167], v6, s[20:23], 0 offen offset:0
    buffer_load_dwordx4 v[168:171], v6, s[20:23], 0 offen offset:1024
    buffer_load_dwordx4 v[172:175], v6, s[20:23], 0 offen offset:2048
    buffer_load_dwordx4 v[176:179], v6, s[20:23], 0 offen offset:3072
    buffer_load_dwordx4 v[180:183], v7, s[20:23], 0 offen offset:0
    buffer_load_dwordx4 v[184:187], v7, s[20:23], 0 offen offset:1024
    buffer_load_dwordx4 v[188:191], v7, s[20:23], 0 offen offset:2048
    buffer_load_dwordx4 v[192:195], v7, s[20:23], 0 offen offset:3072
    s_add_u32 s41, s40, 15
    s_lshr_b32 s41, s41, 4
    s_waitcnt lgkmcnt(0)
    v_readfirstlane_b32 s42, v196
    v_mfma_f32_16x16x4_4b_bf16 v[112:127], v[198:199], v[144:145], 0
    v_mfma_f32_16x16x4_4b_bf16 v[128:143], v[198:199], v[146:147], 0
    s_nop 7
    s_nop 3
    v_cvt_pk_bf16_f32 v112, v112, v113
    v_cvt_pk_bf16_f32 v113, v114, v115
    v_cvt_pk_bf16_f32 v114, v116, v117
    v_cvt_pk_bf16_f32 v115, v118, v119
    v_cvt_pk_bf16_f32 v116, v120, v121
    v_cvt_pk_bf16_f32 v117, v122, v123
    v_cvt_pk_bf16_f32 v118, v124, v125
    v_cvt_pk_bf16_f32 v119, v126, v127
    ds_write_b64 v209, v[112:113] offset:0
    ds_write_b64 v209, v[114:115] offset:720
    ds_write_b64 v209, v[116:117] offset:1440
    ds_write_b64 v209, v[118:119] offset:2160
    v_mfma_f32_16x16x4_4b_bf16 v[112:127], v[198:199], v[148:149], 0
    v_cvt_pk_bf16_f32 v128, v128, v129
    v_cvt_pk_bf16_f32 v129, v130, v131
    v_cvt_pk_bf16_f32 v130, v132, v133
    v_cvt_pk_bf16_f32 v131, v134, v135
    v_cvt_pk_bf16_f32 v132, v136, v137
    v_cvt_pk_bf16_f32 v133, v138, v139
    v_cvt_pk_bf16_f32 v134, v140, v141
    v_cvt_pk_bf16_f32 v135, v142, v143
    ds_write_b64 v209, v[128:129] offset:2880
    ds_write_b64 v209, v[130:131] offset:3600
    ds_write_b64 v209, v[132:133] offset:4320
    ds_write_b64 v209, v[134:135] offset:5040
    s_cmp_le_u32 s41, 12
    s_cbranch_scc1 K2_TLAST
    v_mfma_f32_16x16x4_4b_bf16 v[128:143], v[198:199], v[150:151], 0
    s_nop 3
    v_cvt_pk_bf16_f32 v112, v112, v113
    v_cvt_pk_bf16_f32 v113, v114, v115
    v_cvt_pk_bf16_f32 v114, v116, v117
    v_cvt_pk_bf16_f32 v115, v118, v119
    v_cvt_pk_bf16_f32 v116, v120, v121
    v_cvt_pk_bf16_f32 v117, v122, v123
    v_cvt_pk_bf16_f32 v118, v124, v125
    v_cvt_pk_bf16_f32 v119, v126, v127
    ds_write_b64 v209, v[112:113] offset:5760
    ds_write_b64 v209, v[114:115] offset:6480
    ds_write_b64 v209, v[116:117] offset:7200
    ds_write_b64 v209, v[118:119] offset:7920
    s_nop 1
    v_cvt_pk_bf16_f32 v128, v128, v129
    v_cvt_pk_bf16_f32 v129, v130, v131
    v_cvt_pk_bf16_f32 v130, v132, v133
    v_cvt_pk_bf16_f32 v131, v134, v135
    v_cvt_pk_bf16_f32 v132, v136, v137
    v_cvt_pk_bf16_f32 v133, v138, v139
    v_cvt_pk_bf16_f32 v134, v140, v141
    v_cvt_pk_bf16_f32 v135, v142, v143
    ds_write_b64 v209, v[128:129] offset:8640
    ds_write_b64 v209, v[130:131] offset:9360
    ds_write_b64 v209, v[132:133] offset:10080
    ds_write_b64 v209, v[134:135] offset:10800
    s_branch K2_TDONE
K2_TLAST:
    s_nop 3
    v_cvt_pk_bf16_f32 v112, v112, v113
    v_cvt_pk_bf16_f32 v113, v114, v115
    v_cvt_pk_bf16_f32 v114, v116, v117
    v_cvt_pk_bf16_f32 v115, v118, v119
    v_cvt_pk_bf16_f32 v116, v120, v121
    v_cvt_pk_bf16_f32 v117, v122, v123
    v_cvt_pk_bf16_f32 v118, v124, v125
    v_cvt_pk_bf16_f32 v119, v126, v127
    ds_write_b64 v209, v[112:113] offset:5760
    ds_write_b64 v209, v[114:115] offset:6480
    ds_write_b64 v209, v[116:117] offset:7200
    ds_write_b64 v209, v[118:119] offset:7920
K2_TDONE:
    s_nop 3
    s_sub_u32 s41, s40, 1
    v_mfma_f32_4x4x4_16b_bf16 v[128:131], v[154:155], v[156:157], 0 cbsz:4 abid:0
    v_mfma_f32_4x4x4_16b_bf16 v[132:135], v[154:155], v[160:161], 0 cbsz:4 abid:0
    s_waitcnt lgkmcnt(0)
    ds_read_b64 v[152:153], v2 offset:0
    s_nop 3
    v_exp_f32 v144, v128
    v_exp_f32 v145, v129
    s_nop 0
    v_pk_add_f32 v[144:145], v[144:145], s[48:49]
    v_rcp_f32 v144, v144
    v_rcp_f32 v145, v145
    s_nop 0
    v_pk_mul_f32 v[128:129], v[128:129], v[144:145]
    v_exp_f32 v146, v132
    v_exp_f32 v147, v133
    s_nop 0
    v_pk_add_f32 v[146:147], v[146:147], s[48:49]
    s_waitcnt vmcnt(15) lgkmcnt(0)
    v_mfma_f32_4x4x4_16b_bf16 v[112:115], v[152:153], v[48:49], 0 cbsz:4 abid:0
    v_mfma_f32_4x4x4_16b_bf16 v[116:119], v[152:153], v[50:51], 0 cbsz:4 abid:0
    s_lshl_b32 s44, s3, 2
    v_mov_b32 v215, s44
    s_xor_b32 s44, s44, 16
    v_mov_b32 v216, s44
.p2align 6
K2_MAIN:
    s_waitcnt vmcnt(6) lgkmcnt(1)
    v_mfma_f32_4x4x4_16b_bf16 v[136:139], v[154:155], v[156:157], 0 cbsz:4 abid:1
    v_exp_f32 v144, v130
    v_mfma_f32_4x4x4_16b_bf16 v[120:123], v[152:153], v[52:53], 0 cbsz:4 abid:1
    v_exp_f32 v145, v131
    v_mfma_f32_4x4x4_16b_bf16 v[124:127], v[152:153], v[54:55], 0 cbsz:4 abid:1
    v_rcp_f32 v146, v146
    v_rcp_f32 v147, v147
    s_bfe_u32 s44, s42, 0x40000
    v_pk_mul_f32 v[132:133], v[132:133], v[146:147]
    s_set_gpr_idx_on s44, 0xc
    v_pk_fma_f32 v[8:9], v[112:113], v[128:129], v[8:9] op_sel_hi:[1,0,1]
    v_pk_fma_f32 v[18:19], v[114:115], v[128:129], v[18:19] op_sel_hi:[1,0,1]
    v_pk_fma_f32 v[28:29], v[116:117], v[132:133], v[28:29] op_sel_hi:[1,0,1]
    v_pk_fma_f32 v[38:39], v[118:119], v[132:133], v[38:39] op_sel_hi:[1,0,1]
    s_set_gpr_idx_off
    v_pk_add_f32 v[144:145], v[144:145], s[48:49]
    buffer_load_dwordx4 v[48:51], v[96:97], s[4:7], 0 idxen offen
    ds_read_b32 v100, v3 offset:680
    s_waitcnt vmcnt(6) lgkmcnt(1)
    v_mfma_f32_4x4x4_16b_bf16 v[140:143], v[154:155], v[160:161], 0 cbsz:4 abid:1
    v_exp_f32 v146, v134
    v_mfma_f32_4x4x4_16b_bf16 v[112:115], v[152:153], v[56:57], 0 cbsz:4 abid:2
    v_exp_f32 v147, v135
    v_mfma_f32_4x4x4_16b_bf16 v[116:119], v[152:153], v[58:59], 0 cbsz:4 abid:2
    v_rcp_f32 v144, v144
    v_rcp_f32 v145, v145
    s_bfe_u32 s44, s42, 0x40004
    v_pk_mul_f32 v[130:131], v[130:131], v[144:145]
    s_set_gpr_idx_on s44, 0xc
    v_pk_fma_f32 v[8:9], v[120:121], v[128:129], v[8:9] op_sel:[0,1,0] op_sel_hi:[1,1,1]
    v_pk_fma_f32 v[18:19], v[122:123], v[128:129], v[18:19] op_sel:[0,1,0] op_sel_hi:[1,1,1]
    v_pk_fma_f32 v[28:29], v[124:125], v[132:133], v[28:29] op_sel:[0,1,0] op_sel_hi:[1,1,1]
    v_pk_fma_f32 v[38:39], v[126:127], v[132:133], v[38:39] op_sel:[0,1,0] op_sel_hi:[1,1,1]
    s_set_gpr_idx_off
    v_pk_add_f32 v[146:147], v[146:147], s[48:49]
    buffer_load_dwordx4 v[52:55], v[98:99], s[4:7], 0 idxen offen
    ds_read_b32 v102, v3 offset:684
    ds_read_b32 v197, v3 offset:708
    s_waitcnt vmcnt(6) lgkmcnt(2)
    v_exp_f32 v144, v136
    v_mfma_f32_4x4x4_16b_bf16 v[120:123], v[152:153], v[60:61], 0 cbsz:4 abid:3
    v_exp_f32 v145, v137
    v_mfma_f32_4x4x4_16b_bf16 v[124:127], v[152:153], v[62:63], 0 cbsz:4 abid:3
    v_rcp_f32 v146, v146
    v_rcp_f32 v147, v147
    s_bfe_u32 s44, s42, 0x40008
    v_pk_mul_f32 v[134:135], v[134:135], v[146:147]
    s_set_gpr_idx_on s44, 0xc
    v_pk_fma_f32 v[8:9], v[112:113], v[130:131], v[8:9] op_sel_hi:[1,0,1]
    v_pk_fma_f32 v[18:19], v[114:115], v[130:131], v[18:19] op_sel_hi:[1,0,1]
    v_pk_fma_f32 v[28:29], v[116:117], v[134:135], v[28:29] op_sel_hi:[1,0,1]
    v_pk_fma_f32 v[38:39], v[118:119], v[134:135], v[38:39] op_sel_hi:[1,0,1]
    s_set_gpr_idx_off
    v_pk_add_f32 v[144:145], v[144:145], s[48:49]
    buffer_load_dwordx4 v[56:59], v[100:101], s[4:7], 0 idxen offen
    ds_read_b32 v104, v3 offset:688
    s_waitcnt vmcnt(6) lgkmcnt(2)
    v_exp_f32 v146, v140
    v_mfma_f32_4x4x4_16b_bf16 v[112:115], v[152:153], v[64:65], 0 cbsz:4 abid:4
    v_exp_f32 v147, v141
    v_mfma_f32_4x4x4_16b_bf16 v[116:119], v[152:153], v[66:67], 0 cbsz:4 abid:4
    v_rcp_f32 v144, v144
    v_rcp_f32 v145, v145
    s_bfe_u32 s44, s42, 0x4000c
    v_pk_mul_f32 v[136:137], v[136:137], v[144:145]
    s_set_gpr_idx_on s44, 0xc
    v_pk_fma_f32 v[8:9], v[120:121], v[130:131], v[8:9] op_sel:[0,1,0] op_sel_hi:[1,1,1]
    v_pk_fma_f32 v[18:19], v[122:123], v[130:131], v[18:19] op_sel:[0,1,0] op_sel_hi:[1,1,1]
    v_pk_fma_f32 v[28:29], v[124:125], v[134:135], v[28:29] op_sel:[0,1,0] op_sel_hi:[1,1,1]
    v_pk_fma_f32 v[38:39], v[126:127], v[134:135], v[38:39] op_sel:[0,1,0] op_sel_hi:[1,1,1]
    s_set_gpr_idx_off
    v_pk_add_f32 v[146:147], v[146:147], s[48:49]
    buffer_load_dwordx4 v[60:63], v[102:103], s[4:7], 0 idxen offen
    ds_read_b32 v106, v3 offset:692
    s_waitcnt lgkmcnt(2)
    v_readfirstlane_b32 s43, v197
    s_waitcnt vmcnt(6) lgkmcnt(1)
    v_mfma_f32_4x4x4_16b_bf16 v[128:131], v[154:155], v[156:157], 0 cbsz:4 abid:2
    v_exp_f32 v144, v138
    v_mfma_f32_4x4x4_16b_bf16 v[120:123], v[152:153], v[68:69], 0 cbsz:4 abid:5
    v_exp_f32 v145, v139
    v_mfma_f32_4x4x4_16b_bf16 v[124:127], v[152:153], v[70:71], 0 cbsz:4 abid:5
    v_rcp_f32 v146, v146
    v_rcp_f32 v147, v147
    s_bfe_u32 s44, s42, 0x40010
    v_pk_mul_f32 v[140:141], v[140:141], v[146:147]
    s_set_gpr_idx_on s44, 0xc
    v_pk_fma_f32 v[8:9], v[112:113], v[136:137], v[8:9] op_sel_hi:[1,0,1]
    v_pk_fma_f32 v[18:19], v[114:115], v[136:137], v[18:19] op_sel_hi:[1,0,1]
    v_pk_fma_f32 v[28:29], v[116:117], v[140:141], v[28:29] op_sel_hi:[1,0,1]
    v_pk_fma_f32 v[38:39], v[118:119], v[140:141], v[38:39] op_sel_hi:[1,0,1]
    s_set_gpr_idx_off
    v_pk_add_f32 v[144:145], v[144:145], s[48:49]
    buffer_load_dwordx4 v[64:67], v[104:105], s[4:7], 0 idxen offen
    ds_read_b32 v108, v3 offset:696
    s_waitcnt vmcnt(6) lgkmcnt(1)
    v_mfma_f32_4x4x4_16b_bf16 v[132:135], v[154:155], v[160:161], 0 cbsz:4 abid:2
    v_exp_f32 v146, v142
    v_mfma_f32_4x4x4_16b_bf16 v[112:115], v[152:153], v[72:73], 0 cbsz:4 abid:6
    v_exp_f32 v147, v143
    v_mfma_f32_4x4x4_16b_bf16 v[116:119], v[152:153], v[74:75], 0 cbsz:4 abid:6
    v_rcp_f32 v144, v144
    v_rcp_f32 v145, v145
    s_bfe_u32 s44, s42, 0x40014
    v_pk_mul_f32 v[138:139], v[138:139], v[144:145]
    s_set_gpr_idx_on s44, 0xc
    v_pk_fma_f32 v[8:9], v[120:121], v[136:137], v[8:9] op_sel:[0,1,0] op_sel_hi:[1,1,1]
    v_pk_fma_f32 v[18:19], v[122:123], v[136:137], v[18:19] op_sel:[0,1,0] op_sel_hi:[1,1,1]
    v_pk_fma_f32 v[28:29], v[124:125], v[140:141], v[28:29] op_sel:[0,1,0] op_sel_hi:[1,1,1]
    v_pk_fma_f32 v[38:39], v[126:127], v[140:141], v[38:39] op_sel:[0,1,0] op_sel_hi:[1,1,1]
    s_set_gpr_idx_off
    v_pk_add_f32 v[146:147], v[146:147], s[48:49]
    buffer_load_dwordx4 v[68:71], v[106:107], s[4:7], 0 idxen offen
    ds_read_b32 v110, v3 offset:700
    s_waitcnt vmcnt(6) lgkmcnt(1)
    v_exp_f32 v144, v128
    v_mfma_f32_4x4x4_16b_bf16 v[120:123], v[152:153], v[76:77], 0 cbsz:4 abid:7
    v_exp_f32 v145, v129
    v_mfma_f32_4x4x4_16b_bf16 v[124:127], v[152:153], v[78:79], 0 cbsz:4 abid:7
    v_rcp_f32 v146, v146
    v_rcp_f32 v147, v147
    s_bfe_u32 s44, s42, 0x40018
    v_pk_mul_f32 v[142:143], v[142:143], v[146:147]
    s_set_gpr_idx_on s44, 0xc
    v_pk_fma_f32 v[8:9], v[112:113], v[138:139], v[8:9] op_sel_hi:[1,0,1]
    v_pk_fma_f32 v[18:19], v[114:115], v[138:139], v[18:19] op_sel_hi:[1,0,1]
    v_pk_fma_f32 v[28:29], v[116:117], v[142:143], v[28:29] op_sel_hi:[1,0,1]
    v_pk_fma_f32 v[38:39], v[118:119], v[142:143], v[38:39] op_sel_hi:[1,0,1]
    s_set_gpr_idx_off
    v_pk_add_f32 v[144:145], v[144:145], s[48:49]
    buffer_load_dwordx4 v[72:75], v[108:109], s[4:7], 0 idxen offen
    ds_read_b32 v80, v3 offset:1360
    s_waitcnt vmcnt(6) lgkmcnt(1)
    v_exp_f32 v146, v132
    v_mfma_f32_4x4x4_16b_bf16 v[112:115], v[152:153], v[48:49], 0 cbsz:4 abid:8
    v_exp_f32 v147, v133
    v_mfma_f32_4x4x4_16b_bf16 v[116:119], v[152:153], v[50:51], 0 cbsz:4 abid:8
    v_rcp_f32 v144, v144
    v_rcp_f32 v145, v145
    s_bfe_u32 s44, s42, 0x4001c
    v_pk_mul_f32 v[128:129], v[128:129], v[144:145]
    s_set_gpr_idx_on s44, 0xc
    v_pk_fma_f32 v[8:9], v[120:121], v[138:139], v[8:9] op_sel:[0,1,0] op_sel_hi:[1,1,1]
    v_pk_fma_f32 v[18:19], v[122:123], v[138:139], v[18:19] op_sel:[0,1,0] op_sel_hi:[1,1,1]
    v_pk_fma_f32 v[28:29], v[124:125], v[142:143], v[28:29] op_sel:[0,1,0] op_sel_hi:[1,1,1]
    v_pk_fma_f32 v[38:39], v[126:127], v[142:143], v[38:39] op_sel:[0,1,0] op_sel_hi:[1,1,1]
    s_set_gpr_idx_off
    v_pk_add_f32 v[146:147], v[146:147], s[48:49]
    buffer_load_dwordx4 v[76:79], v[110:111], s[4:7], 0 idxen offen
    ds_read_b32 v82, v3 offset:1364
    s_sub_u32 s41, s41, 8
    s_cbranch_scc1 K2_MAIN_DONE
    s_waitcnt vmcnt(6) lgkmcnt(1)
    v_mfma_f32_4x4x4_16b_bf16 v[136:139], v[154:155], v[156:157], 0 cbsz:4 abid:3
    v_exp_f32 v144, v130
    v_mfma_f32_4x4x4_16b_bf16 v[120:123], v[152:153], v[52:53], 0 cbsz:4 abid:9
    v_exp_f32 v145, v131
    v_mfma_f32_4x4x4_16b_bf16 v[124:127], v[152:153], v[54:55], 0 cbsz:4 abid:9
    v_rcp_f32 v146, v146
    v_rcp_f32 v147, v147
    s_bfe_u32 s44, s43, 0x40000
    v_pk_mul_f32 v[132:133], v[132:133], v[146:147]
    s_set_gpr_idx_on s44, 0xc
    v_pk_fma_f32 v[8:9], v[112:113], v[128:129], v[8:9] op_sel_hi:[1,0,1]
    v_pk_fma_f32 v[18:19], v[114:115], v[128:129], v[18:19] op_sel_hi:[1,0,1]
    v_pk_fma_f32 v[28:29], v[116:117], v[132:133], v[28:29] op_sel_hi:[1,0,1]
    v_pk_fma_f32 v[38:39], v[118:119], v[132:133], v[38:39] op_sel_hi:[1,0,1]
    s_set_gpr_idx_off
    v_pk_add_f32 v[144:145], v[144:145], s[48:49]
    buffer_load_dwordx4 v[48:51], v[80:81], s[4:7], 0 idxen offen
    ds_read_b32 v84, v3 offset:1368
    s_waitcnt vmcnt(6) lgkmcnt(1)
    v_mfma_f32_4x4x4_16b_bf16 v[140:143], v[154:155], v[160:161], 0 cbsz:4 abid:3
    v_exp_f32 v146, v134
    v_mfma_f32_4x4x4_16b_bf16 v[112:115], v[152:153], v[56:57], 0 cbsz:4 abid:10
    v_exp_f32 v147, v135
    v_mfma_f32_4x4x4_16b_bf16 v[116:119], v[152:153], v[58:59], 0 cbsz:4 abid:10
    v_rcp_f32 v144, v144
    v_rcp_f32 v145, v145
    s_bfe_u32 s44, s43, 0x40004
    v_pk_mul_f32 v[130:131], v[130:131], v[144:145]
    s_set_gpr_idx_on s44, 0xc
    v_pk_fma_f32 v[8:9], v[120:121], v[128:129], v[8:9] op_sel:[0,1,0] op_sel_hi:[1,1,1]
    v_pk_fma_f32 v[18:19], v[122:123], v[128:129], v[18:19] op_sel:[0,1,0] op_sel_hi:[1,1,1]
    v_pk_fma_f32 v[28:29], v[124:125], v[132:133], v[28:29] op_sel:[0,1,0] op_sel_hi:[1,1,1]
    v_pk_fma_f32 v[38:39], v[126:127], v[132:133], v[38:39] op_sel:[0,1,0] op_sel_hi:[1,1,1]
    s_set_gpr_idx_off
    v_pk_add_f32 v[146:147], v[146:147], s[48:49]
    buffer_load_dwordx4 v[52:55], v[82:83], s[4:7], 0 idxen offen
    ds_read_b32 v86, v3 offset:1372
    s_waitcnt vmcnt(6) lgkmcnt(1)
    v_exp_f32 v144, v136
    v_mfma_f32_4x4x4_16b_bf16 v[120:123], v[152:153], v[60:61], 0 cbsz:4 abid:11
    v_exp_f32 v145, v137
    v_mfma_f32_4x4x4_16b_bf16 v[124:127], v[152:153], v[62:63], 0 cbsz:4 abid:11
    v_rcp_f32 v146, v146
    v_rcp_f32 v147, v147
    s_bfe_u32 s44, s43, 0x40008
    v_pk_mul_f32 v[134:135], v[134:135], v[146:147]
    s_set_gpr_idx_on s44, 0xc
    v_pk_fma_f32 v[8:9], v[112:113], v[130:131], v[8:9] op_sel_hi:[1,0,1]
    v_pk_fma_f32 v[18:19], v[114:115], v[130:131], v[18:19] op_sel_hi:[1,0,1]
    v_pk_fma_f32 v[28:29], v[116:117], v[134:135], v[28:29] op_sel_hi:[1,0,1]
    v_pk_fma_f32 v[38:39], v[118:119], v[134:135], v[38:39] op_sel_hi:[1,0,1]
    s_set_gpr_idx_off
    v_pk_add_f32 v[144:145], v[144:145], s[48:49]
    buffer_load_dwordx4 v[56:59], v[84:85], s[4:7], 0 idxen offen
    ds_read_b32 v88, v3 offset:1376
    ds_read_b64 v[154:155], v2 offset:1232
    ds_read_b32 v196, v3 offset:1424
    s_waitcnt vmcnt(6) lgkmcnt(3)
    v_exp_f32 v146, v140
    v_mfma_f32_4x4x4_16b_bf16 v[112:115], v[152:153], v[64:65], 0 cbsz:4 abid:12
    v_exp_f32 v147, v141
    v_mfma_f32_4x4x4_16b_bf16 v[116:119], v[152:153], v[66:67], 0 cbsz:4 abid:12
    v_rcp_f32 v144, v144
    v_rcp_f32 v145, v145
    s_bfe_u32 s44, s43, 0x4000c
    v_pk_mul_f32 v[136:137], v[136:137], v[144:145]
    s_set_gpr_idx_on s44, 0xc
    v_pk_fma_f32 v[8:9], v[120:121], v[130:131], v[8:9] op_sel:[0,1,0] op_sel_hi:[1,1,1]
    v_pk_fma_f32 v[18:19], v[122:123], v[130:131], v[18:19] op_sel:[0,1,0] op_sel_hi:[1,1,1]
    v_pk_fma_f32 v[28:29], v[124:125], v[134:135], v[28:29] op_sel:[0,1,0] op_sel_hi:[1,1,1]
    v_pk_fma_f32 v[38:39], v[126:127], v[134:135], v[38:39] op_sel:[0,1,0] op_sel_hi:[1,1,1]
    s_set_gpr_idx_off
    v_pk_add_f32 v[146:147], v[146:147], s[48:49]
    buffer_load_dwordx4 v[60:63], v[86:87], s[4:7], 0 idxen offen
    ds_read_b32 v90, v3 offset:1380
    v_mov_b32 v217, s41
    ds_write_b32 v215, v217 offset:1088
    ds_read_b32 v217, v216 offset:1088
    s_waitcnt vmcnt(6) lgkmcnt(4)
    v_mfma_f32_4x4x4_16b_bf16 v[128:131], v[154:155], v[156:157], 0 cbsz:4 abid:0
    v_exp_f32 v144, v138
    v_mfma_f32_4x4x4_16b_bf16 v[120:123], v[152:153], v[68:69], 0 cbsz:4 abid:13
    v_exp_f32 v145, v139
    v_mfma_f32_4x4x4_16b_bf16 v[124:127], v[152:153], v[70:71], 0 cbsz:4 abid:13
    v_rcp_f32 v146, v146
    v_rcp_f32 v147, v147
    s_bfe_u32 s44, s43, 0x40010
    v_pk_mul_f32 v[140:141], v[140:141], v[146:147]
    s_set_gpr_idx_on s44, 0xc
    v_pk_fma_f32 v[8:9], v[112:113], v[136:137], v[8:9] op_sel_hi:[1,0,1]
    v_pk_fma_f32 v[18:19], v[114:115], v[136:137], v[18:19] op_sel_hi:[1,0,1]
    v_pk_fma_f32 v[28:29], v[116:117], v[140:141], v[28:29] op_sel_hi:[1,0,1]
    v_pk_fma_f32 v[38:39], v[118:119], v[140:141], v[38:39] op_sel_hi:[1,0,1]
    s_set_gpr_idx_off
    v_pk_add_f32 v[144:145], v[144:145], s[48:49]
    buffer_load_dwordx4 v[64:67], v[88:89], s[4:7], 0 idxen offen
    ds_read_b32 v92, v3 offset:1384
    s_waitcnt lgkmcnt(4)
    v_readfirstlane_b32 s42, v196
    s_waitcnt vmcnt(6) lgkmcnt(3)
    v_mfma_f32_4x4x4_16b_bf16 v[132:135], v[154:155], v[160:161], 0 cbsz:4 abid:0
    v_exp_f32 v146, v142
    v_mfma_f32_4x4x4_16b_bf16 v[112:115], v[152:153], v[72:73], 0 cbsz:4 abid:14
    v_exp_f32 v147, v143
    v_mfma_f32_4x4x4_16b_bf16 v[116:119], v[152:153], v[74:75], 0 cbsz:4 abid:14
    v_rcp_f32 v144, v144
    v_rcp_f32 v145, v145
    s_bfe_u32 s44, s43, 0x40014
    v_pk_mul_f32 v[138:139], v[138:139], v[144:145]
    s_set_gpr_idx_on s44, 0xc
    v_pk_fma_f32 v[8:9], v[120:121], v[136:137], v[8:9] op_sel:[0,1,0] op_sel_hi:[1,1,1]
    v_pk_fma_f32 v[18:19], v[122:123], v[136:137], v[18:19] op_sel:[0,1,0] op_sel_hi:[1,1,1]
    v_pk_fma_f32 v[28:29], v[124:125], v[140:141], v[28:29] op_sel:[0,1,0] op_sel_hi:[1,1,1]
    v_pk_fma_f32 v[38:39], v[126:127], v[140:141], v[38:39] op_sel:[0,1,0] op_sel_hi:[1,1,1]
    s_set_gpr_idx_off
    v_pk_add_f32 v[146:147], v[146:147], s[48:49]
    buffer_load_dwordx4 v[68:71], v[90:91], s[4:7], 0 idxen offen
    ds_read_b32 v94, v3 offset:1388
    s_waitcnt vmcnt(6) lgkmcnt(1)
    v_exp_f32 v144, v128
    v_mfma_f32_4x4x4_16b_bf16 v[120:123], v[152:153], v[76:77], 0 cbsz:4 abid:15
    v_exp_f32 v145, v129
    v_mfma_f32_4x4x4_16b_bf16 v[124:127], v[152:153], v[78:79], 0 cbsz:4 abid:15
    ds_read_b64 v[152:153], v2 offset:720
    v_rcp_f32 v146, v146
    v_rcp_f32 v147, v147
    s_bfe_u32 s44, s43, 0x40018
    v_pk_mul_f32 v[142:143], v[142:143], v[146:147]
    s_set_gpr_idx_on s44, 0xc
    v_pk_fma_f32 v[8:9], v[112:113], v[138:139], v[8:9] op_sel_hi:[1,0,1]
    v_pk_fma_f32 v[18:19], v[114:115], v[138:139], v[18:19] op_sel_hi:[1,0,1]
    v_pk_fma_f32 v[28:29], v[116:117], v[142:143], v[28:29] op_sel_hi:[1,0,1]
    v_pk_fma_f32 v[38:39], v[118:119], v[142:143], v[38:39] op_sel_hi:[1,0,1]
    s_set_gpr_idx_off
    v_pk_add_f32 v[144:145], v[144:145], s[48:49]
    buffer_load_dwordx4 v[72:75], v[92:93], s[4:7], 0 idxen offen
    ds_read_b32 v96, v3 offset:1392
    s_waitcnt lgkmcnt(4)
    v_readfirstlane_b32 s62, v217
    s_waitcnt vmcnt(6) lgkmcnt(1)
    v_exp_f32 v146, v132
    v_mfma_f32_4x4x4_16b_bf16 v[112:115], v[152:153], v[48:49], 0 cbsz:4 abid:0
    v_exp_f32 v147, v133
    v_mfma_f32_4x4x4_16b_bf16 v[116:119], v[152:153], v[50:51], 0 cbsz:4 abid:0
    v_rcp_f32 v144, v144
    v_rcp_f32 v145, v145
    s_bfe_u32 s44, s43, 0x4001c
    v_pk_mul_f32 v[128:129], v[128:129], v[144:145]
    s_set_gpr_idx_on s44, 0xc
    v_pk_fma_f32 v[8:9], v[120:121], v[138:139], v[8:9] op_sel:[0,1,0] op_sel_hi:[1,1,1]
    v_pk_fma_f32 v[18:19], v[122:123], v[138:139], v[18:19] op_sel:[0,1,0] op_sel_hi:[1,1,1]
    v_pk_fma_f32 v[28:29], v[124:125], v[142:143], v[28:29] op_sel:[0,1,0] op_sel_hi:[1,1,1]
    v_pk_fma_f32 v[38:39], v[126:127], v[142:143], v[38:39] op_sel:[0,1,0] op_sel_hi:[1,1,1]
    s_set_gpr_idx_off
    v_pk_add_f32 v[146:147], v[146:147], s[48:49]
    buffer_load_dwordx4 v[76:79], v[94:95], s[4:7], 0 idxen offen
    ds_read_b32 v98, v3 offset:1396
    s_cmp_gt_i32 s41, s62
    s_setprio 0
    s_cbranch_scc0 K2_PD15
    s_setprio 1
K2_PD15:
    v_add_u32 v3, 720, v3
    v_add_u32 v2, 720, v2
    s_sub_u32 s41, s41, 8
    s_cbranch_scc1 K2_MAIN_DONE
    s_branch K2_MAIN
K2_MAIN_DONE:
    s_waitcnt vmcnt(0) lgkmcnt(0)
K2_ROUND_END:
    s_add_u32 s31, s31, s30
    s_cmp_eq_u32 s30, 256
    s_cbranch_scc1 K2_EPI
    s_cmp_ge_u32 s31, s47
    s_cbranch_scc1 K2_EPI
    s_branch K2_AGAIN
K2_GOSLOW:
    s_mov_b64 exec, -1
    v_and_b32 v4, 7, v1
    v_lshlrev_b32 v4, 2, v4
    ds_read_b32 v6, v4 offset:1024
    s_waitcnt lgkmcnt(0)
    s_nop 1
    v_max_u32_dpp v6, v6, v6 row_shr:1 row_mask:0xf bank_mask:0xf
    s_nop 1
    v_max_u32_dpp v6, v6, v6 row_shr:2 row_mask:0xf bank_mask:0xf
    s_nop 1
    v_max_u32_dpp v6, v6, v6 row_shr:4 row_mask:0xf bank_mask:0xf
    s_nop 1
    v_max_u32_dpp v6, v6, v6 row_shr:8 row_mask:0xf bank_mask:0xf
    s_nop 0
    v_readlane_b32 s47, v6, 15
    s_movk_i32 s30, 28
K2_AGAIN:
    s_waitcnt vmcnt(0) lgkmcnt(0)
    s_barrier
    v_mov_b32 v5, 0
    v_lshlrev_b32 v6, 2, v0
    v_cmp_le_u32 vcc, 128, v0
    v_add_u32 v7, 640, v6
    s_nop 0
    v_cndmask_b32 v6, v6, v7, vcc
    v_cmp_gt_u32 vcc, 192, v0
    s_and_saveexec_b64 s[54:55], vcc
    ds_write_b32 v6, v5
    s_mov_b64 exec, s[54:55]
    v_lshrrev_b32 v6, 1, v0
    v_mul_u32_u24 v6, 720, v6
    v_and_b32 v7, 1, v0
    v_lshl_add_u32 v6, v7, 2, v6
    v_cmp_gt_u32 vcc, 256, v0
    s_and_saveexec_b64 s[54:55], vcc
    ds_write_b32 v6, v5 offset:2624
    s_mov_b64 exec, s[54:55]
    s_branch K2_ROUND
K2_EPI:
    v_pk_mul_f32 v[8:9], v[8:9], s[50:51]
    v_pk_mul_f32 v[10:11], v[10:11], s[50:51]
    v_pk_mul_f32 v[12:13], v[12:13], s[50:51]
    v_pk_mul_f32 v[14:15], v[14:15], s[50:51]
    v_pk_mul_f32 v[16:17], v[16:17], s[50:51]
    v_pk_mul_f32 v[18:19], v[18:19], s[50:51]
    v_pk_mul_f32 v[20:21], v[20:21], s[50:51]
    v_pk_mul_f32 v[22:23], v[22:23], s[50:51]
    v_pk_mul_f32 v[24:25], v[24:25], s[50:51]
    v_pk_mul_f32 v[26:27], v[26:27], s[50:51]
    v_pk_mul_f32 v[28:29], v[28:29], s[50:51]
    v_pk_mul_f32 v[30:31], v[30:31], s[50:51]
    v_pk_mul_f32 v[32:33], v[32:33], s[50:51]
    v_pk_mul_f32 v[34:35], v[34:35], s[50:51]
    v_pk_mul_f32 v[36:37], v[36:37], s[50:51]
    v_pk_mul_f32 v[38:39], v[38:39], s[50:51]
    v_pk_mul_f32 v[40:41], v[40:41], s[50:51]
    v_pk_mul_f32 v[42:43], v[42:43], s[50:51]
    v_pk_mul_f32 v[44:45], v[44:45], s[50:51]
    v_pk_mul_f32 v[46:47], v[46:47], s[50:51]
    s_mul_i32 s44, s3, 20
    v_mov_b32 v4, s44
    ds_read_b32 v80, v4 offset:1664
    ds_read_b32 v81, v4 offset:1668
    ds_read_b32 v82, v4 offset:1672
    ds_read_b32 v83, v4 offset:1676
    ds_read_b32 v84, v4 offset:1680
    v_lshlrev_b32 v5, 2, v1
    v_add_u32 v5, 94080, v5
    v_cvt_pk_bf16_f32 v48, v8, v28
    v_cvt_pk_bf16_f32 v49, v9, v29
    v_cvt_pk_bf16_f32 v50, v18, v38
    v_cvt_pk_bf16_f32 v51, v19, v39
    v_cvt_pk_bf16_f32 v52, v10, v30
    v_cvt_pk_bf16_f32 v53, v11, v31
    v_cvt_pk_bf16_f32 v54, v20, v40
    v_cvt_pk_bf16_f32 v55, v21, v41
    v_cvt_pk_bf16_f32 v56, v12, v32
    v_cvt_pk_bf16_f32 v57, v13, v33
    v_cvt_pk_bf16_f32 v58, v22, v42
    v_cvt_pk_bf16_f32 v59, v23, v43
    v_cvt_pk_bf16_f32 v60, v14, v34
    v_cvt_pk_bf16_f32 v61, v15, v35
    v_cvt_pk_bf16_f32 v62, v24, v44
    v_cvt_pk_bf16_f32 v63, v25, v45
    v_cvt_pk_bf16_f32 v64, v16, v36
    v_cvt_pk_bf16_f32 v65, v17, v37
    v_cvt_pk_bf16_f32 v66, v26, v46
    v_cvt_pk_bf16_f32 v67, v27, v47
    s_waitcnt lgkmcnt(0)
    v_mul_u32_u24 v80, 1088, v80
    v_add_u32 v80, v80, v5
    v_mul_u32_u24 v81, 1088, v81
    v_add_u32 v81, v81, v5
    v_mul_u32_u24 v82, 1088, v82
    v_add_u32 v82, v82, v5
    v_mul_u32_u24 v83, 1088, v83
    v_add_u32 v83, v83, v5
    v_mul_u32_u24 v84, 1088, v84
    v_add_u32 v84, v84, v5
    ds_write_b32 v80, v48 offset:0
    ds_write_b32 v80, v49 offset:272
    ds_write_b32 v80, v50 offset:544
    ds_write_b32 v80, v51 offset:816
    ds_write_b32 v81, v52 offset:0
    ds_write_b32 v81, v53 offset:272
    ds_write_b32 v81, v54 offset:544
    ds_write_b32 v81, v55 offset:816
    ds_write_b32 v82, v56 offset:0
    ds_write_b32 v82, v57 offset:272
    ds_write_b32 v82, v58 offset:544
    ds_write_b32 v82, v59 offset:816
    ds_write_b32 v83, v60 offset:0
    ds_write_b32 v83, v61 offset:272
    ds_write_b32 v83, v62 offset:544
    ds_write_b32 v83, v63 offset:816
    ds_write_b32 v84, v64 offset:0
    ds_write_b32 v84, v65 offset:272
    ds_write_b32 v84, v66 offset:544
    ds_write_b32 v84, v67 offset:816
    s_waitcnt vmcnt(0) lgkmcnt(0)
    s_barrier
    s_lshr_b32 s52, s3, 2
    s_mul_i32 s44, s52, 21760
    s_add_u32 s44, s44, 94080
    v_and_b32 v5, 15, v1
    v_mul_u32_u24 v4, 272, v5
    v_lshrrev_b32 v6, 4, v1
    v_lshl_add_u32 v4, v6, 4, v4
    v_add_u32 v4, s44, v4
    s_mul_i32 s44, s52, 20
    s_add_u32 s44, s44, s26
    s_lshl_b32 s44, s44, 10
    s_and_b32 s45, s3, 3
    s_lshl_b32 s45, s45, 8
    s_add_u32 s44, s44, s45
    v_lshlrev_b32 v6, 10, v6
    v_lshl_add_u32 v6, v5, 4, v6
    v_add_u32 v6, s44, v6
    ds_read_b128 v[48:51], v4 offset:0
    ds_read_b128 v[52:55], v4 offset:64
    ds_read_b128 v[56:59], v4 offset:128
    ds_read_b128 v[60:63], v4 offset:192
    ds_read_b128 v[64:67], v4 offset:4352
    ds_read_b128 v[68:71], v4 offset:4416
    ds_read_b128 v[72:75], v4 offset:4480
    ds_read_b128 v[76:79], v4 offset:4544
    s_waitcnt lgkmcnt(4)
    v_mfma_f32_16x16x32_bf16 v[80:83], v[48:51], v[164:167], 0
    v_mfma_f32_16x16x32_bf16 v[84:87], v[48:51], v[180:183], 0
    v_mfma_f32_16x16x32_bf16 v[80:83], v[52:55], v[168:171], v[80:83]
    v_mfma_f32_16x16x32_bf16 v[84:87], v[52:55], v[184:187], v[84:87]
    v_mfma_f32_16x16x32_bf16 v[80:83], v[56:59], v[172:175], v[80:83]
    v_mfma_f32_16x16x32_bf16 v[84:87], v[56:59], v[188:191], v[84:87]
    v_mfma_f32_16x16x32_bf16 v[80:83], v[60:63], v[176:179], v[80:83]
    v_mfma_f32_16x16x32_bf16 v[84:87], v[60:63], v[192:195], v[84:87]
    s_nop 7
    v_cvt_pk_bf16_f32 v96, v80, v81
    v_cvt_pk_bf16_f32 v97, v82, v83
    v_cvt_pk_bf16_f32 v98, v84, v85
    v_cvt_pk_bf16_f32 v99, v86, v87
    buffer_store_dwordx4 v[96:99], v6, s[16:19], 0 offen sc1 nt
    s_nop 1
    ds_read_b128 v[48:51], v4 offset:8704
    ds_read_b128 v[52:55], v4 offset:8768
    ds_read_b128 v[56:59], v4 offset:8832
    ds_read_b128 v[60:63], v4 offset:8896
    s_waitcnt lgkmcnt(4)
    v_mfma_f32_16x16x32_bf16 v[88:91], v[64:67], v[164:167], 0
    v_mfma_f32_16x16x32_bf16 v[92:95], v[64:67], v[180:183], 0
    v_mfma_f32_16x16x32_bf16 v[88:91], v[68:71], v[168:171], v[88:91]
    v_mfma_f32_16x16x32_bf16 v[92:95], v[68:71], v[184:187], v[92:95]
    v_mfma_f32_16x16x32_bf16 v[88:91], v[72:75], v[172:175], v[88:91]
    v_mfma_f32_16x16x32_bf16 v[92:95], v[72:75], v[188:191], v[92:95]
    v_mfma_f32_16x16x32_bf16 v[88:91], v[76:79], v[176:179], v[88:91]
    v_mfma_f32_16x16x32_bf16 v[92:95], v[76:79], v[192:195], v[92:95]
    s_nop 7
    v_cvt_pk_bf16_f32 v100, v88, v89
    v_cvt_pk_bf16_f32 v101, v90, v91
    v_cvt_pk_bf16_f32 v102, v92, v93
    v_cvt_pk_bf16_f32 v103, v94, v95
    v_add_u32 v6, 4096, v6
    buffer_store_dwordx4 v[100:103], v6, s[16:19], 0 offen sc1 nt
    s_nop 1
    ds_read_b128 v[64:67], v4 offset:13056
    ds_read_b128 v[68:71], v4 offset:13120
    ds_read_b128 v[72:75], v4 offset:13184
    ds_read_b128 v[76:79], v4 offset:13248
    s_waitcnt lgkmcnt(4)
    v_mfma_f32_16x16x32_bf16 v[80:83], v[48:51], v[164:167], 0
    v_mfma_f32_16x16x32_bf16 v[84:87], v[48:51], v[180:183], 0
    v_mfma_f32_16x16x32_bf16 v[80:83], v[52:55], v[168:171], v[80:83]
    v_mfma_f32_16x16x32_bf16 v[84:87], v[52:55], v[184:187], v[84:87]
    v_mfma_f32_16x16x32_bf16 v[80:83], v[56:59], v[172:175], v[80:83]
    v_mfma_f32_16x16x32_bf16 v[84:87], v[56:59], v[188:191], v[84:87]
    v_mfma_f32_16x16x32_bf16 v[80:83], v[60:63], v[176:179], v[80:83]
    v_mfma_f32_16x16x32_bf16 v[84:87], v[60:63], v[192:195], v[84:87]
    s_nop 7
    v_cvt_pk_bf16_f32 v96, v80, v81
    v_cvt_pk_bf16_f32 v97, v82, v83
    v_cvt_pk_bf16_f32 v98, v84, v85
    v_cvt_pk_bf16_f32 v99, v86, v87
    v_add_u32 v6, 4096, v6
    buffer_store_dwordx4 v[96:99], v6, s[16:19], 0 offen sc1 nt
    s_nop 1
    ds_read_b128 v[48:51], v4 offset:17408
    ds_read_b128 v[52:55], v4 offset:17472
    ds_read_b128 v[56:59], v4 offset:17536
    ds_read_b128 v[60:63], v4 offset:17600
    s_waitcnt lgkmcnt(4)
    v_mfma_f32_16x16x32_bf16 v[88:91], v[64:67], v[164:167], 0
    v_mfma_f32_16x16x32_bf16 v[92:95], v[64:67], v[180:183], 0
    v_mfma_f32_16x16x32_bf16 v[88:91], v[68:71], v[168:171], v[88:91]
    v_mfma_f32_16x16x32_bf16 v[92:95], v[68:71], v[184:187], v[92:95]
    v_mfma_f32_16x16x32_bf16 v[88:91], v[72:75], v[172:175], v[88:91]
    v_mfma_f32_16x16x32_bf16 v[92:95], v[72:75], v[188:191], v[92:95]
    v_mfma_f32_16x16x32_bf16 v[88:91], v[76:79], v[176:179], v[88:91]
    v_mfma_f32_16x16x32_bf16 v[92:95], v[76:79], v[192:195], v[92:95]
    s_nop 7
    v_cvt_pk_bf16_f32 v100, v88, v89
    v_cvt_pk_bf16_f32 v101, v90, v91
    v_cvt_pk_bf16_f32 v102, v92, v93
    v_cvt_pk_bf16_f32 v103, v94, v95
    v_add_u32 v6, 4096, v6
    buffer_store_dwordx4 v[100:103], v6, s[16:19], 0 offen sc1 nt
    s_nop 1
    s_waitcnt lgkmcnt(0)
    v_mfma_f32_16x16x32_bf16 v[80:83], v[48:51], v[164:167], 0
    v_mfma_f32_16x16x32_bf16 v[84:87], v[48:51], v[180:183], 0
    v_mfma_f32_16x16x32_bf16 v[80:83], v[52:55], v[168:171], v[80:83]
    v_mfma_f32_16x16x32_bf16 v[84:87], v[52:55], v[184:187], v[84:87]
    v_mfma_f32_16x16x32_bf16 v[80:83], v[56:59], v[172:175], v[80:83]
    v_mfma_f32_16x16x32_bf16 v[84:87], v[56:59], v[188:191], v[84:87]
    v_mfma_f32_16x16x32_bf16 v[80:83], v[60:63], v[176:179], v[80:83]
    v_mfma_f32_16x16x32_bf16 v[84:87], v[60:63], v[192:195], v[84:87]
    s_nop 7
    v_cvt_pk_bf16_f32 v96, v80, v81
    v_cvt_pk_bf16_f32 v97, v82, v83
    v_cvt_pk_bf16_f32 v98, v84, v85
    v_cvt_pk_bf16_f32 v99, v86, v87
    v_add_u32 v6, 4096, v6
    buffer_store_dwordx4 v[96:99], v6, s[16:19], 0 offen sc1 nt
    s_nop 1
K2_END:
    s_endpgm
.section .rodata,"a"
.p2align 6
.amdhsa_kernel tfn_sort_kernel
  .amdhsa_next_free_vgpr 80
  .amdhsa_next_free_sgpr 40
  .amdhsa_accum_offset 80
  .amdhsa_group_segment_fixed_size 0
  .amdhsa_kernarg_size 88
  .amdhsa_user_sgpr_count 2
  .amdhsa_user_sgpr_kernarg_segment_ptr 1
  .amdhsa_system_sgpr_workgroup_id_x 1
  .amdhsa_float_denorm_mode_32 3
.end_amdhsa_kernel
.p2align 6
.amdhsa_kernel tfn_main_kernel
  .amdhsa_next_free_vgpr 256
  .amdhsa_next_free_sgpr 80
  .amdhsa_accum_offset 256
  .amdhsa_group_segment_fixed_size 0
  .amdhsa_kernarg_size 88
  .amdhsa_user_sgpr_count 2
  .amdhsa_user_sgpr_kernarg_segment_ptr 1
  .amdhsa_system_sgpr_workgroup_id_x 1
  .amdhsa_float_denorm_mode_32 3
.end_amdhsa_kernel
```
